```python
import torch

def _softmax(x, axis=-1):
    return torch.softmax(x, dim=axis)
def _gelu(x):
    return torch.nn.functional.gelu(x, approximate="tanh")
def _silu(x):
    return torch.nn.functional.silu(x)
def _sigmoid(x):
    return torch.sigmoid(x)
def _layernorm(x, axis=-1, eps=1e-5):
    m = x.mean(dim=axis, keepdim=True)
    v = x.var(dim=axis, keepdim=True, unbiased=False)
    return (x - m) / torch.sqrt(v + eps)
def _scatter_add(tgt, idx, src, axis=0):
    return tgt.clone().index_add_(axis, idx, src)
def _segment_sum(src, seg, n):
    out = torch.zeros((n,) + src.shape[1:], dtype=src.dtype)
    return out.index_add_(0, seg, src)
def _pad(x, pw):
    flat = tuple(v for pair in reversed(pw) for v in pair)
    return torch.nn.functional.pad(x, flat)

kernel_name = 'standalone__rmsnorm__sampling'

def setup_inputs():

    _w = (lambda a: (lambda t: t.to(torch.bfloat16) if t.is_floating_point() else t)(torch.as_tensor(a)))
    B, S, D = 1024, 8, 1024
    return {
        "x": _w((lambda *s: torch.randn(*s, dtype=torch.bfloat16) * 0.05)(B, S, D)),
        "g": _w((lambda *s: torch.randn(*s, dtype=torch.bfloat16) * 0.05)(D) + 1.0),
    }

def reference(x, g):
    rms = torch.sqrt((x * x).mean(axis=-1, keepdims=True) + 1e-6)
    return x / rms * g
```

```asm
; @launch grid=(256,1,1) block=(256,1,1) lds=0
.amdgcn_target "amdgcn-amd-amdhsa--gfx950"

.set ACC, 4
.set GF, 6
.set T, 22
.set GRAW, 24
.set X, 40

.macro LOAD_ROW row, vaddr
    global_load_dwordx4 v[X+8*\row:X+8*\row+3], \vaddr, s[4:5] offset:(\row%4)*2048-4096 nt
    global_load_dwordx4 v[X+8*\row+4:X+8*\row+7], \vaddr, s[4:5] offset:(\row%4)*2048-3072 nt
.endm

.macro STORE_ROW row, vaddr, hint
    global_store_dwordx4 \vaddr, v[X+8*\row:X+8*\row+3], s[8:9] offset:(\row%4)*2048-4096 sc1 \hint
    global_store_dwordx4 \vaddr, v[X+8*\row+4:X+8*\row+7], s[8:9] offset:(\row%4)*2048-3072 sc1 \hint
.endm

.macro LO dst, src
    v_lshlrev_b32 v[\dst], 16, v[\src]
.endm

.macro HI dst, src
    v_and_b32 v[\dst], s16, v[\src]
.endm

.macro ROW x
    v_dot2c_f32_bf16 v[ACC], v[\x], v[\x]
    v_dot2c_f32_bf16 v[ACC], v[\x+1], v[\x+1]
    v_dot2c_f32_bf16 v[ACC], v[\x+2], v[\x+2]
    v_dot2c_f32_bf16 v[ACC], v[\x+3], v[\x+3]
    v_dot2c_f32_bf16 v[ACC], v[\x+4], v[\x+4]
    v_dot2c_f32_bf16 v[ACC], v[\x+5], v[\x+5]
    v_dot2c_f32_bf16 v[ACC], v[\x+6], v[\x+6]
    v_dot2c_f32_bf16 v[ACC], v[\x+7], v[\x+7]
    LO T, \x
    HI T+1, \x
    LO T+2, \x+1
    v_add_f32_dpp v[ACC], v[ACC], v[ACC] quad_perm:[1,0,3,2] row_mask:0xf bank_mask:0xf
    HI T+3, \x+1
    LO T+4, \x+2
    v_add_f32_dpp v[ACC], v[ACC], v[ACC] quad_perm:[2,3,0,1] row_mask:0xf bank_mask:0xf
    HI T+5, \x+2
    LO T+6, \x+3
    v_add_f32_dpp v[ACC], v[ACC], v[ACC] row_half_mirror row_mask:0xf bank_mask:0xf
    HI T+7, \x+3
    LO T+8, \x+4
    v_add_f32_dpp v[ACC], v[ACC], v[ACC] row_mirror row_mask:0xf bank_mask:0xf
    HI T+9, \x+4
    LO T+10, \x+5
    v_add_f32_dpp v[ACC], v[ACC], v[ACC] row_bcast:15 row_mask:0xa bank_mask:0xf
    HI T+11, \x+5
    LO T+12, \x+6
    v_add_f32_dpp v[ACC], v[ACC], v[ACC] row_bcast:31 row_mask:0xc bank_mask:0xf
    v_fmamk_f32 v[ACC], v[ACC], 0x3a800000, v0
    v_rsq_f32 v[ACC], v[ACC]
    HI T+13, \x+6
    v_readlane_b32 s18, v[ACC], 63
    LO T+14, \x+7
    HI T+15, \x+7
    .irp d, 0, 2, 4, 6, 8, 10, 12, 14
    v_pk_mul_f32 v[T+\d:T+\d+1], v[T+\d:T+\d+1], v[GF+\d:GF+\d+1]
    .endr
    .irp d, 0, 2, 4, 6, 8, 10, 12, 14
    v_pk_mul_f32 v[T+\d:T+\d+1], v[T+\d:T+\d+1], s[18:19] op_sel_hi:[1,0]
    .endr
    .irp d, 0, 1, 2, 3, 4, 5, 6, 7
    v_cvt_pk_bf16_f32 v[\x+\d], v[T+2*\d], v[T+2*\d+1]
    .endr
.endm

.text
.globl standalone__rmsnorm__sampling_kernel
.p2align 8
.type standalone__rmsnorm__sampling_kernel,@function
standalone__rmsnorm__sampling_kernel:
    s_load_dwordx4 s[4:7], s[0:1], 0
    s_cmpk_ge_u32 s2, 256
    s_cbranch_scc1 L_end
    s_lshl_b32 s3, s2, 14
    s_bitset1_b32 s3, 12
    s_getpc_b64 s[10:11]
    v_mov_b32 v1, 0
    v_lshl_add_u64 v[4:5], v[0:1], 4, s[10:11]
    global_load_dword v5, v[4:5], off
    v_mul_u32_u24 v1, 0x10010, v0
    v_and_b32 v2, 0xc003f0, v1
    v_or_b32 v2, s3, v2
    s_waitcnt lgkmcnt(0)

    LOAD_ROW 0, v2
    LOAD_ROW 1, v2
    v_and_b32 v1, 0x3f0, v2
    global_load_dwordx4 v[GRAW:GRAW+3], v1, s[6:7]
    global_load_dwordx4 v[GRAW+4:GRAW+7], v1, s[6:7] offset:1024
    LOAD_ROW 2, v2
    LOAD_ROW 3, v2
    v_add_u32 v3, 0x2000, v2
    LOAD_ROW 4, v3
    LOAD_ROW 5, v3
    LOAD_ROW 6, v3
    LOAD_ROW 7, v3
    s_load_dwordx2 s[8:9], s[0:1], 16
    s_mov_b32 s16, 0xffff0000
    v_mov_b32 v0, 0x358637bd

    v_mov_b32 v[ACC], 0
    s_waitcnt vmcnt(12)
    .irp d, 0, 1, 2, 3, 4, 5, 6, 7
    LO GF+2*\d, GRAW+\d
    HI GF+2*\d+1, GRAW+\d
    .endr
    ROW X
    v_mov_b32 v[ACC], 0
    ROW X+8
    .irp r, 2, 3, 4, 5, 6, 7
    v_mov_b32 v[ACC], 0
    s_waitcnt vmcnt(14-2*\r)
    ROW X+8*\r
    .endr

    s_waitcnt lgkmcnt(0)
    .irp r, 0, 1, 2, 3
    STORE_ROW \r, v2, nt
    .endr
    .irp r, 4, 5, 6
    STORE_ROW \r, v3, nt
    .endr
    STORE_ROW 7, v3
L_end:
    s_endpgm
    .fill (standalone__rmsnorm__sampling_kernel + 4224 - .) / 4, 4, 0xbf810000

.section .rodata,"a"
.p2align 6
.amdhsa_kernel standalone__rmsnorm__sampling_kernel
  .amdhsa_next_free_vgpr 104
  .amdhsa_next_free_sgpr 32
  .amdhsa_accum_offset 104
  .amdhsa_group_segment_fixed_size 0
  .amdhsa_kernarg_size 40
  .amdhsa_user_sgpr_count 2
  .amdhsa_user_sgpr_kernarg_segment_ptr 1
  .amdhsa_system_sgpr_workgroup_id_x 1
  .amdhsa_float_denorm_mode_32 3
.end_amdhsa_kernel
```
